```python
import torch

def _softmax(x, axis=-1):
    return torch.softmax(x, dim=axis)
def _gelu(x):
    return torch.nn.functional.gelu(x, approximate="tanh")
def _silu(x):
    return torch.nn.functional.silu(x)
def _sigmoid(x):
    return torch.sigmoid(x)
def _layernorm(x, axis=-1, eps=1e-5):
    m = x.mean(dim=axis, keepdim=True)
    v = x.var(dim=axis, keepdim=True, unbiased=False)
    return (x - m) / torch.sqrt(v + eps)
def _scatter_add(tgt, idx, src, axis=0):
    return tgt.clone().index_add_(axis, idx, src)
def _segment_sum(src, seg, n):
    out = torch.zeros((n,) + src.shape[1:], dtype=src.dtype)
    return out.index_add_(0, seg, src)
def _pad(x, pw):
    flat = tuple(v for pair in reversed(pw) for v in pair)
    return torch.nn.functional.pad(x, flat)

kernel_name = 'standalone__moe_arch_mod__prompt'

def setup_inputs():

    _w = (lambda a: (lambda t: t.to(torch.bfloat16) if t.is_floating_point() else t)(torch.as_tensor(a)))
    B, S, D, F, C = 1, 2048, 576, 4608, 1
    return {
        "x": _w((lambda *s: torch.randn(*s, dtype=torch.bfloat16) * 0.1)(B, S, D)),
        "w_r": _w((lambda *s: torch.randn(*s, dtype=torch.bfloat16) * 0.1)(D)),
        "w_gate": _w((lambda *s: torch.randn(*s, dtype=torch.bfloat16) * 0.1)(D, F)),
        "w_up": _w((lambda *s: torch.randn(*s, dtype=torch.bfloat16) * 0.1)(D, F)),
        "w_down": _w((lambda *s: torch.randn(*s, dtype=torch.bfloat16) * 0.1)(F, D)),
    }

def reference(x, w_r, w_gate, w_up, w_down):
    B, S, D = x.shape
    C = 1
    r = x @ w_r
    idx = torch.argsort(-r, axis=-1)[:, :C]
    idx_e = (lambda x, n, axis: torch.repeat_interleave(x, n, dim=axis))(idx.reshape(B, C, 1), D, axis=2)
    x_sel = (lambda x, i, axis: torch.take_along_dim(x, i, dim=axis))(x, idx_e, axis=1)
    g = _silu(x_sel @ w_gate)
    u = x_sel @ w_up
    y = (g * u) @ w_down
    r_sel = _sigmoid((lambda x, i, axis: torch.take_along_dim(x, i, dim=axis))(r, idx, axis=1))
    y = y * r_sel.reshape(B, C, 1)
    b_off = (torch.arange(B) * S).reshape(B, 1)
    flat_idx = (idx + b_off).reshape(B * C)
    zero = (x * 0.0).reshape(B * S, D)
    upd = _scatter_add(zero, flat_idx, y.reshape(B * C, D), axis=0)
    return x + upd.reshape(B, S, D)
```

```asm
; @launch grid=(256,1,1) block=(512,1,1) lds=3328
.amdgcn_target "amdgcn-amd-amdhsa--gfx950"
.text
.globl standalone__moe_arch_mod__prompt_kernel
.p2align 12
.fill 832, 4, 0xBF800000
.p2align 8
.type standalone__moe_arch_mod__prompt_kernel,@function
standalone__moe_arch_mod__prompt_kernel:
    s_load_dwordx16 s[4:19], s[0:1], 0
    s_cmp_ge_u32 s2, 256
    s_cbranch_scc1 L_exit0
    v_readfirstlane_b32 s20, v0
    v_and_b32 v0, 63, v0
    s_and_b32 s21, s2, 7
    s_lshr_b32 s22, s2, 3
    s_lshr_b32 s20, s20, 6
    s_cmp_lt_u32 s20, 4
    s_cbranch_scc1 L_notp
    s_cmp_eq_u32 s20, 4
    s_cbranch_scc1 L_warm1
    s_cmp_eq_u32 s20, 5
    s_cbranch_scc1 L_warm2
    s_cmp_eq_u32 s20, 6
    s_cbranch_scc1 L_warm3
    s_branch L_warm_r
L_spare0:
    s_cmp_lg_u32 s20, 0
    s_cbranch_scc1 L_warm_s
    s_lshl_b32 s24, s21, 13
    s_add_u32 s24, s24, 131072
    v_min_u32 v40, 31, v0
    v_lshl_add_u32 v40, v40, 7, s24
    s_waitcnt lgkmcnt(0)
    s_load_dword s30, s[18:19], 0
    s_cmp_lg_u32 s22, 27
    s_cbranch_scc1 L_spare
    global_load_dwordx2 v[8:9], v40, s[18:19] sc1
    s_branch L_spare
L_exit0:
    s_endpgm
L_notp:
    s_cmp_lg_u32 s20, 3
    s_cbranch_scc1 L_w
    s_lshl_b32 s24, s2, 3
    s_setprio 3
    v_lshrrev_b32 v1, 3, v0
    v_add_u32 v1, s24, v1
    v_and_b32 v2, 7, v0
    v_lshlrev_b32 v2, 4, v2
    s_movk_i32 s25, 1152
    v_mad_u32_u24 v4, v1, s25, v2
    s_lshl_b32 s23, s21, 6
    s_add_u32 s23, s23, s22
    s_lshl_b32 s23, s23, 7
    s_add_u32 s23, s23, 131072
    v_mov_b32 v3, s23
    v_lshlrev_b32 v5, 4, v0
    s_movk_i32 m0, 2048
    s_waitcnt lgkmcnt(0)
    global_load_lds_dwordx4 v5, s[6:7]
    s_mov_b64 exec, 0xff
    global_load_lds_dwordx4 v5, s[6:7] offset:1024
    s_mov_b64 exec, -1
    global_load_dwordx4 v[8:11], v4, s[4:5] offset:0
    global_load_dwordx4 v[12:15], v4, s[4:5] offset:128
    global_load_dwordx4 v[16:19], v4, s[4:5] offset:256
    global_load_dwordx4 v[20:23], v4, s[4:5] offset:384
    global_load_dwordx4 v[24:27], v4, s[4:5] offset:512
    global_load_dwordx4 v[28:31], v4, s[4:5] offset:640
    global_load_dwordx4 v[32:35], v4, s[4:5] offset:768
    global_load_dwordx4 v[36:39], v4, s[4:5] offset:896
    global_load_dwordx4 v[40:43], v4, s[4:5] offset:1024
    global_load_dword v88, v3, s[18:19] sc1
    s_load_dword s30, s[18:19], 0
    s_branch L_r2
L_w:
    s_cmp_ge_u32 s22, 27
    s_cbranch_scc1 L_spare0
    s_mul_i32 s23, s22, 57
    s_lshr_b32 s23, s23, 9
    s_mul_i32 s32, s23, 9
    s_sub_u32 s32, s22, s32
    s_mul_i32 s31, s21, 3
    s_add_u32 s31, s31, s23
    s_mul_i32 s31, s31, 3
    s_add_u32 s31, s31, s20
    v_lshrrev_b32 v8, 4, v0
    s_lshl_b32 s23, s32, 5
    v_add_u32 v1, s23, v8
    s_mov_b32 s24, 18432
    v_mul_lo_u32 v1, v1, s24
    v_and_b32 v9, 7, v0
    v_lshlrev_b32 v9, 4, v9
    s_lshl_b32 s25, s31, 7
    v_add3_u32 v1, v1, v9, s25
    v_and_b32 v10, 8, v0
    v_cmp_ne_u32 vcc, 0, v10
    s_mov_b32 s34, 9216
    s_mov_b32 s35, 0
    s_mov_b32 s36, 64512
    s_mov_b32 s37, 0
    s_waitcnt lgkmcnt(0)
    v_mov_b32 v2, s8
    v_mov_b32 v3, s9
    v_mov_b32 v4, s10
    v_mov_b32 v5, s11
    v_cndmask_b32 v2, v2, v4, vcc
    v_cndmask_b32 v3, v3, v5, vcc
    v_add_co_u32 v2, vcc, v2, v1
    s_load_dword s30, s[18:19], 0
    s_nop 0
    v_addc_co_u32 v3, vcc, 0, v3, vcc
    v_and_b32 v6, 24, v0
    v_lshlrev_b32 v6, 1, v6
    v_lshrrev_b32 v7, 5, v0
    v_lshl_add_u32 v6, v7, 1, v6
    s_lshl_b32 s23, s31, 6
    v_add_u32 v6, s23, v6
    s_movk_i32 s24, 1152
    v_mul_lo_u32 v6, v6, s24
    s_lshl_b32 s26, s32, 7
    s_add_u32 s26, s26, 2880
    v_add3_u32 v6, v6, v9, s26
    v_add_u32 v7, 9216, v6
    s_mov_b32 s27, 0x05040100
    s_mov_b32 s28, 0x07060302
    v_lshlrev_b32 v11, 4, v8
    s_mul_i32 s23, s31, 4608
    s_add_u32 s23, s23, 1050624
    v_lshl_add_u32 v13, v0, 4, s23
    s_lshl_b32 s24, s32, 9
    s_add_u32 s23, s23, s24
    s_sub_u32 s23, s23, 2048
    v_and_b32 v12, 4, v0
    v_lshlrev_b32 v12, 6, v12
    v_lshl_add_u32 v12, v10, 4, v12
    v_and_b32 v14, 3, v0
    v_lshl_add_u32 v12, v14, 5, v12
    v_add3_u32 v12, v12, v11, s23
    s_lshl_b32 s23, s20, 9
    v_lshlrev_b32 v14, 5, v10
    v_lshl_add_u32 v14, v9, 1, v14
    v_add_u32 v14, s23, v14
    s_getreg_b32 s33, hwreg(HW_REG_XCC_ID, 0, 3)
    global_load_dwordx4 v[16:19], v[2:3], off nt
    v_lshl_add_u64 v[2:3], v[2:3], 0, s[34:35]
    global_load_dwordx4 v[20:23], v[2:3], off nt
    v_lshl_add_u64 v[2:3], v[2:3], 0, s[36:37]
    global_load_dwordx4 v[24:27], v[2:3], off nt
    v_lshl_add_u64 v[2:3], v[2:3], 0, s[34:35]
    global_load_dwordx4 v[28:31], v[2:3], off nt
    v_lshl_add_u64 v[2:3], v[2:3], 0, s[36:37]
    global_load_dwordx4 v[32:35], v[2:3], off nt
    v_lshl_add_u64 v[2:3], v[2:3], 0, s[34:35]
    global_load_dwordx4 v[36:39], v[2:3], off nt
    v_lshl_add_u64 v[2:3], v[2:3], 0, s[36:37]
    global_load_dwordx4 v[40:43], v[2:3], off nt
    v_lshl_add_u64 v[2:3], v[2:3], 0, s[34:35]
    s_barrier
    global_load_dwordx4 v[44:47], v[2:3], off nt
    v_lshl_add_u64 v[2:3], v[2:3], 0, s[36:37]
    s_waitcnt vmcnt(7)
    global_load_dwordx4 v[48:51], v[2:3], off nt
    v_lshl_add_u64 v[2:3], v[2:3], 0, s[34:35]
    s_waitcnt vmcnt(7)
    global_load_dwordx4 v[52:55], v[2:3], off nt
    v_lshl_add_u64 v[2:3], v[2:3], 0, s[36:37]
    v_perm_b32 v112, v20, v16, s27
    v_perm_b32 v116, v20, v16, s28
    v_perm_b32 v120, v21, v17, s27
    v_perm_b32 v124, v21, v17, s28
    v_perm_b32 v128, v22, v18, s27
    v_perm_b32 v132, v22, v18, s28
    v_perm_b32 v136, v23, v19, s27
    v_perm_b32 v140, v23, v19, s28
    s_waitcnt vmcnt(7)
    global_load_dwordx4 v[56:59], v[2:3], off nt
    v_lshl_add_u64 v[2:3], v[2:3], 0, s[34:35]
    s_waitcnt lgkmcnt(0)
    s_add_u32 s30, s30, 1
    s_lshl_b32 s23, s33, 18
    s_xor_b32 s30, s30, s23
    s_bfe_u32 s38, s30, 393216
    s_bfe_u32 s39, s30, 393222
    s_bfe_u32 s40, s30, 393228
    s_bfe_u32 s41, s30, 393234
    s_waitcnt vmcnt(7)
    global_load_dwordx4 v[60:63], v[2:3], off nt
    v_lshl_add_u64 v[2:3], v[2:3], 0, s[36:37]
    v_perm_b32 v113, v28, v24, s27
    v_perm_b32 v117, v28, v24, s28
    v_perm_b32 v121, v29, v25, s27
    v_perm_b32 v125, v29, v25, s28
    v_perm_b32 v129, v30, v26, s27
    v_perm_b32 v133, v30, v26, s28
    v_perm_b32 v137, v31, v27, s27
    v_perm_b32 v141, v31, v27, s28
    s_waitcnt vmcnt(7)
    global_load_dwordx4 v[64:67], v[2:3], off nt
    v_lshl_add_u64 v[2:3], v[2:3], 0, s[34:35]
    s_branch L_skip1
L_warm1:
    s_branch L_p
L_skip1:
    s_waitcnt vmcnt(7)
    global_load_dwordx4 v[68:71], v[2:3], off nt
    v_lshl_add_u64 v[2:3], v[2:3], 0, s[36:37]
    v_perm_b32 v114, v36, v32, s27
    v_perm_b32 v118, v36, v32, s28
    v_perm_b32 v122, v37, v33, s27
    v_perm_b32 v126, v37, v33, s28
    v_perm_b32 v130, v38, v34, s27
    v_perm_b32 v134, v38, v34, s28
    v_perm_b32 v138, v39, v35, s27
    v_perm_b32 v142, v39, v35, s28
    s_waitcnt vmcnt(7)
    global_load_dwordx4 v[72:75], v[2:3], off nt
    v_lshl_add_u64 v[2:3], v[2:3], 0, s[34:35]
    s_waitcnt vmcnt(7)
    global_load_dwordx4 v[76:79], v[2:3], off nt
    v_perm_b32 v115, v44, v40, s27
    v_perm_b32 v119, v44, v40, s28
    v_perm_b32 v123, v45, v41, s27
    v_perm_b32 v127, v45, v41, s28
    v_perm_b32 v131, v46, v42, s27
    v_perm_b32 v135, v46, v42, s28
    v_perm_b32 v139, v47, v43, s27
    v_perm_b32 v143, v47, v43, s28
    global_load_dwordx4 v[80:83], v6, s[12:13] offset:-2880 nt
    global_load_dwordx4 v[84:87], v6, s[12:13] offset:-1728 nt
    s_waitcnt vmcnt(9)
    global_load_dwordx4 v[88:91], v6, s[12:13] offset:1728 nt
    s_waitcnt vmcnt(9)
    global_load_dwordx4 v[92:95], v6, s[12:13] offset:2880 nt
    v_perm_b32 v16, v52, v48, s27
    v_perm_b32 v20, v52, v48, s28
    v_perm_b32 v24, v53, v49, s27
    v_perm_b32 v28, v53, v49, s28
    v_perm_b32 v32, v54, v50, s27
    v_perm_b32 v36, v54, v50, s28
    v_perm_b32 v40, v55, v51, s27
    v_perm_b32 v44, v55, v51, s28
    s_waitcnt vmcnt(9)
    global_load_dwordx4 v[96:99], v7, s[12:13] offset:-2880 nt
    s_waitcnt vmcnt(9)
    global_load_dwordx4 v[100:103], v7, s[12:13] offset:-1728 nt
    v_perm_b32 v17, v60, v56, s27
    v_perm_b32 v21, v60, v56, s28
    v_perm_b32 v25, v61, v57, s27
    v_perm_b32 v29, v61, v57, s28
    v_perm_b32 v33, v62, v58, s27
    v_perm_b32 v37, v62, v58, s28
    v_perm_b32 v41, v63, v59, s27
    v_perm_b32 v45, v63, v59, s28
    s_waitcnt vmcnt(9)
    global_load_dwordx4 v[104:107], v7, s[12:13] offset:1728 nt
    s_waitcnt vmcnt(9)
    global_load_dwordx4 v[108:111], v7, s[12:13] offset:2880 nt
    v_perm_b32 v18, v68, v64, s27
    v_perm_b32 v22, v68, v64, s28
    v_perm_b32 v26, v69, v65, s27
    v_perm_b32 v30, v69, v65, s28
    v_perm_b32 v34, v70, v66, s27
    v_perm_b32 v38, v70, v66, s28
    v_perm_b32 v42, v71, v67, s27
    v_perm_b32 v46, v71, v67, s28
    s_barrier
    ds_read_b128 v[176:179], v11 offset:0
    ds_read_b128 v[180:183], v11 offset:64
    s_waitcnt lgkmcnt(1)
    v_mfma_f32_16x16x32_bf16 v[144:147], v[176:179], v[112:115], 0
    v_mfma_f32_16x16x32_bf16 v[160:163], v[176:179], v[128:131], 0
    v_mfma_f32_16x16x32_bf16 v[148:151], v[176:179], v[116:119], 0
    v_mfma_f32_16x16x32_bf16 v[164:167], v[176:179], v[132:135], 0
    v_mfma_f32_16x16x32_bf16 v[152:155], v[176:179], v[120:123], 0
    v_mfma_f32_16x16x32_bf16 v[168:171], v[176:179], v[136:139], 0
    v_mfma_f32_16x16x32_bf16 v[156:159], v[176:179], v[124:127], 0
    v_mfma_f32_16x16x32_bf16 v[172:175], v[176:179], v[140:143], 0
    s_waitcnt vmcnt(8) lgkmcnt(0)
    v_perm_b32 v19, v76, v72, s27
    v_perm_b32 v35, v78, v74, s27
    v_perm_b32 v23, v76, v72, s28
    v_mfma_f32_16x16x32_bf16 v[144:147], v[180:183], v[16:19], v[144:147]
    v_perm_b32 v39, v78, v74, s28
    v_mfma_f32_16x16x32_bf16 v[160:163], v[180:183], v[32:35], v[160:163]
    v_perm_b32 v27, v77, v73, s27
    v_mfma_f32_16x16x32_bf16 v[148:151], v[180:183], v[20:23], v[148:151]
    v_perm_b32 v43, v79, v75, s27
    v_mfma_f32_16x16x32_bf16 v[164:167], v[180:183], v[36:39], v[164:167]
    v_perm_b32 v31, v77, v73, s28
    v_mfma_f32_16x16x32_bf16 v[152:155], v[180:183], v[24:27], v[152:155]
    v_perm_b32 v47, v79, v75, s28
    v_mfma_f32_16x16x32_bf16 v[168:171], v[180:183], v[40:43], v[168:171]
    v_mfma_f32_16x16x32_bf16 v[156:159], v[180:183], v[28:31], v[156:159]
    v_mfma_f32_16x16x32_bf16 v[172:175], v[180:183], v[44:47], v[172:175]
    s_nop 1
    v_mov_b32_dpp v144, v160 quad_perm:[0,1,2,3] row_mask:0x2 bank_mask:0xf
    v_bfi_b32 v176, 63, s38, v144
    v_mov_b32_dpp v148, v164 quad_perm:[0,1,2,3] row_mask:0x2 bank_mask:0xf
    v_bfi_b32 v177, 63, s39, v148
    v_mov_b32_dpp v152, v168 quad_perm:[0,1,2,3] row_mask:0x2 bank_mask:0xf
    v_bfi_b32 v178, 63, s40, v152
    v_mov_b32_dpp v156, v172 quad_perm:[0,1,2,3] row_mask:0x2 bank_mask:0xf
    v_bfi_b32 v179, 63, s41, v156
    s_mov_b32 exec_hi, 0
    global_store_dwordx4 v12, v[176:179], s[18:19]
    s_mov_b32 exec_hi, -1
    s_waitcnt vmcnt(7)
    v_perm_b32 v48, v84, v80, s27
    v_perm_b32 v52, v84, v80, s28
    v_perm_b32 v56, v85, v81, s27
    v_perm_b32 v60, v85, v81, s28
    v_perm_b32 v64, v86, v82, s27
    v_perm_b32 v68, v86, v82, s28
    v_perm_b32 v72, v87, v83, s27
    v_perm_b32 v76, v87, v83, s28
    s_waitcnt vmcnt(5)
    v_perm_b32 v49, v92, v88, s27
    v_perm_b32 v53, v92, v88, s28
    v_perm_b32 v57, v93, v89, s27
    v_perm_b32 v61, v93, v89, s28
    v_perm_b32 v65, v94, v90, s27
    v_perm_b32 v69, v94, v90, s28
    v_perm_b32 v73, v95, v91, s27
    v_perm_b32 v77, v95, v91, s28
    s_waitcnt vmcnt(3)
    v_perm_b32 v50, v100, v96, s27
    v_perm_b32 v54, v100, v96, s28
    v_perm_b32 v58, v101, v97, s27
    v_perm_b32 v62, v101, v97, s28
    v_perm_b32 v66, v102, v98, s27
    v_perm_b32 v70, v102, v98, s28
    v_perm_b32 v74, v103, v99, s27
    v_perm_b32 v78, v103, v99, s28
    global_load_dwordx4 v[112:115], v13, s[18:19] offset:-2048 sc1
    global_load_dwordx4 v[116:119], v13, s[18:19] offset:-1024 sc1
    global_load_dwordx4 v[120:123], v13, s[18:19] offset:0 sc1
    global_load_dwordx4 v[124:127], v13, s[18:19] offset:1024 sc1
    s_mov_b32 exec_hi, 0
    global_load_dwordx4 v[128:131], v13, s[18:19] offset:2048 sc1
    s_mov_b32 exec_hi, -1
    s_mov_b32 s29, 0
    s_mov_b32 s34, 0xbfb8aa3b
    s_branch L_w_chk
L_warm2:
    s_branch L_p
L_w_poll:
    s_add_u32 s29, s29, 1
    s_cmp_ge_u32 s29, 60
    s_cbranch_scc1 L_w_far
L_w_chk:
    s_waitcnt vmcnt(4)
    v_xor_b32 v132, s38, v112
    v_xor_b32 v133, s39, v113
    v_xor_b32 v134, s40, v114
    v_xor_b32 v135, s41, v115
    global_load_dwordx4 v[112:115], v13, s[18:19] offset:-2048 sc1
    v_or_b32 v140, v132, v133
    v_or3_b32 v140, v140, v134, v135
    s_waitcnt vmcnt(4)
    v_xor_b32 v136, s38, v116
    v_xor_b32 v137, s39, v117
    v_xor_b32 v138, s40, v118
    v_xor_b32 v139, s41, v119
    global_load_dwordx4 v[116:119], v13, s[18:19] offset:-1024 sc1
    v_or3_b32 v140, v140, v136, v137
    v_or3_b32 v140, v140, v138, v139
    v_pk_add_f32 v[132:133], v[132:133], v[136:137]
    v_pk_add_f32 v[134:135], v[134:135], v[138:139]
    s_waitcnt vmcnt(4)
    v_xor_b32 v136, s38, v120
    v_xor_b32 v137, s39, v121
    v_xor_b32 v138, s40, v122
    v_xor_b32 v139, s41, v123
    global_load_dwordx4 v[120:123], v13, s[18:19] offset:0 sc1
    v_or3_b32 v140, v140, v136, v137
    v_or3_b32 v140, v140, v138, v139
    v_pk_add_f32 v[132:133], v[132:133], v[136:137]
    v_pk_add_f32 v[134:135], v[134:135], v[138:139]
    s_waitcnt vmcnt(4)
    v_xor_b32 v136, s38, v124
    v_xor_b32 v137, s39, v125
    v_xor_b32 v138, s40, v126
    v_xor_b32 v139, s41, v127
    global_load_dwordx4 v[124:127], v13, s[18:19] offset:1024 sc1
    v_or3_b32 v140, v140, v136, v137
    v_or3_b32 v140, v140, v138, v139
    v_pk_add_f32 v[132:133], v[132:133], v[136:137]
    v_pk_add_f32 v[134:135], v[134:135], v[138:139]
    s_waitcnt vmcnt(4)
    s_mov_b32 exec_hi, 0
    v_xor_b32 v136, s38, v128
    v_xor_b32 v137, s39, v129
    v_xor_b32 v138, s40, v130
    v_xor_b32 v139, s41, v131
    global_load_dwordx4 v[128:131], v13, s[18:19] offset:2048 sc1
    v_or3_b32 v140, v140, v136, v137
    v_or3_b32 v140, v140, v138, v139
    v_pk_add_f32 v[132:133], v[132:133], v[136:137]
    v_pk_add_f32 v[134:135], v[134:135], v[138:139]
    s_mov_b32 exec_hi, -1
    v_and_b32 v140, 63, v140
    v_cmp_ne_u32 vcc, 0, v140
    s_cbranch_vccnz L_w_poll
L_w_go:
    v_permlane32_swap_b32 v132, v134
    v_permlane32_swap_b32 v133, v135
    v_pk_add_f32 v[132:133], v[132:133], v[134:135]
    v_cvt_pk_bf16_f32 v134, v132, v133
    v_lshlrev_b32 v132, 16, v134
    v_and_b32 v133, 0xffff0000, v134
    v_pk_mul_f32 v[136:137], v[132:133], s[34:35] op_sel_hi:[1,0]
    v_exp_f32 v136, v136
    v_exp_f32 v137, v137
    v_perm_b32 v51, v108, v104, s27
    v_pk_add_f32 v[136:137], v[136:137], 1.0 op_sel_hi:[1,0]
    v_rcp_f32 v136, v136
    v_rcp_f32 v137, v137
    v_perm_b32 v55, v108, v104, s28
    v_pk_mul_f32 v[136:137], v[132:133], v[136:137]
    v_cvt_pk_bf16_f32 v137, v136, v137
    v_lshlrev_b32 v136, 16, v137
    v_and_b32 v137, 0xffff0000, v137
    v_perm_b32 v59, v109, v105, s27
    v_mul_f32_dpp v136, v132, v136 row_ror:8 row_mask:0xf bank_mask:0xf
    v_mul_f32_dpp v137, v133, v137 row_ror:8 row_mask:0xf bank_mask:0xf
    v_cvt_pk_bf16_f32 v132, v136, v137
    v_perm_b32 v63, v109, v105, s28
    v_perm_b32 v67, v110, v106, s27
    v_mov_b32_dpp v180, v132 quad_perm:[0,0,0,0] row_mask:0xf bank_mask:0xf
    v_mov_b32_dpp v181, v132 quad_perm:[1,1,1,1] row_mask:0xf bank_mask:0xf
    v_mov_b32_dpp v182, v132 quad_perm:[2,2,2,2] row_mask:0xf bank_mask:0xf
    v_mov_b32_dpp v183, v132 quad_perm:[3,3,3,3] row_mask:0xf bank_mask:0xf
    v_perm_b32 v71, v110, v106, s28
    v_perm_b32 v75, v111, v107, s27
    v_mfma_f32_16x16x32_bf16 v[144:147], v[180:183], v[48:51], 0
    v_perm_b32 v79, v111, v107, s28
    v_mfma_f32_16x16x32_bf16 v[148:151], v[180:183], v[52:55], 0
    v_mfma_f32_16x16x32_bf16 v[152:155], v[180:183], v[56:59], 0
    v_mfma_f32_16x16x32_bf16 v[156:159], v[180:183], v[60:63], 0
    v_mfma_f32_16x16x32_bf16 v[160:163], v[180:183], v[64:67], 0
    v_mfma_f32_16x16x32_bf16 v[164:167], v[180:183], v[68:71], 0
    v_mfma_f32_16x16x32_bf16 v[168:171], v[180:183], v[72:75], 0
    v_mfma_f32_16x16x32_bf16 v[172:175], v[180:183], v[76:79], 0
    s_mov_b32 exec_lo, 0xff0000ff
    s_mov_b32 exec_hi, 0
    ds_write2_b32 v14, v144, v148 offset0:64 offset1:65
    s_nop 0
    ds_write2_b32 v14, v152, v156 offset0:66 offset1:67
    s_nop 0
    ds_write2_b32 v14, v160, v164 offset0:68 offset1:69
    s_nop 0
    ds_write2_b32 v14, v168, v172 offset0:70 offset1:71
    s_waitcnt lgkmcnt(0)
    s_barrier
    s_barrier
    s_endpgm
L_p:
    s_cmp_ge_u32 s22, 27
    s_cbranch_scc1 L_exit0
    s_getreg_b32 s33, hwreg(HW_REG_XCC_ID, 0, 3)
    s_mul_i32 s23, s22, 57
    s_lshr_b32 s23, s23, 9
    s_mul_i32 s32, s23, 9
    s_sub_u32 s32, s22, s32
    s_mul_i32 s31, s21, 3
    s_add_u32 s31, s31, s23
    s_mul_i32 s31, s31, 3
    s_waitcnt lgkmcnt(0)
    s_cmp_lg_u32 s20, 6
    s_cbranch_scc1 L_p1
    s_mul_i32 s23, s31, 4608
    s_lshl_b32 s24, s32, 9
    s_add_u32 s23, s23, s24
    s_add_u32 s23, s23, 1048576
    v_lshrrev_b32 v1, 2, v0
    s_movk_i32 s24, 4608
    v_mul_u32_u24 v1, s24, v1
    v_and_b32 v2, 3, v0
    v_lshlrev_b32 v2, 7, v2
    v_add3_u32 v1, v1, v2, s23
    s_mov_b64 exec, 0xfff
    s_barrier
    global_load_dword v3, v1, s[18:19] sc1
    s_endpgm
L_p1:
    s_load_dword s30, s[18:19], 0
    s_barrier
    s_lshl_b32 s26, s33, 12
    s_add_u32 s26, s26, 32768
    s_add_u32 s25, s26, 4096
    s_and_b32 s24, s20, 1
    s_lshl_b32 s24, s24, 6
    v_lshl_add_u32 v4, v0, 2, s24
    s_lshl_b32 s32, s32, 7
    s_add_u32 s32, s32, s24
    v_and_b32 v10, 60, v0
    v_add_u32 v11, s24, v10
    v_and_b32 v12, 1, v0
    v_cmp_eq_u32 s[46:47], 1, v12
    v_lshlrev_b32 v12, 2, v12
    v_lshl_add_u32 v12, v11, 1, v12
    v_and_b32 v11, 12, v0
    v_lshlrev_b32 v11, 2, v11
    v_lshrrev_b32 v13, 4, v0
    v_lshl_add_u32 v11, v13, 2, v11
    v_add_u32 v11, s24, v11
    v_lshrrev_b32 v13, 4, v0
    v_and_b32 v14, 15, v0
    v_lshlrev_b32 v14, 2, v14
    v_lshl_add_u32 v13, v13, 7, v14
    s_lshl_b32 s23, s32, 3
    s_add_u32 s23, s23, 16384
    v_add_u32 v13, s23, v13
    v_mov_b32 v7, 0
    s_mov_b64 exec, 0xffff
    s_branch L_skip3
L_warm3:
    s_branch L_p
L_skip3:
    s_waitcnt lgkmcnt(0)
    s_add_u32 s30, s30, 1
L_p_poll:
    s_load_dwordx2 s[34:35], s[18:19], s26
    s_add_u32 s26, s26, 64
    s_cmp_ge_u32 s26, s25
    s_cbranch_scc1 L_p_slow
    s_waitcnt lgkmcnt(0)
    s_cmp_lg_u32 s35, s30
    s_cbranch_scc1 L_p_poll
L_p_got:
    s_andn2_b32 s24, 0x7ff, s34
    s_mul_i32 s23, s24, 1152
    s_add_u32 s23, s23, s32
    s_load_dwordx16 s[48:63], s[4:5], s23
    v_mov_b32 v6, s24
    ds_write_b32 v7, v6 offset:128
    s_waitcnt lgkmcnt(0)
    v_writelane_b32 v5, s48, 0
    v_writelane_b32 v5, s49, 4
    v_writelane_b32 v5, s50, 8
    v_writelane_b32 v5, s51, 12
    v_writelane_b32 v5, s52, 1
    v_writelane_b32 v5, s53, 5
    v_writelane_b32 v5, s54, 9
    v_writelane_b32 v5, s55, 13
    v_writelane_b32 v5, s56, 2
    v_writelane_b32 v5, s57, 6
    v_writelane_b32 v5, s58, 10
    v_writelane_b32 v5, s59, 14
    v_writelane_b32 v5, s60, 3
    v_writelane_b32 v5, s61, 7
    v_writelane_b32 v5, s62, 11
    v_writelane_b32 v5, s63, 15
    ds_write_b32 v4, v5 offset:0
    s_waitcnt lgkmcnt(0)
    s_barrier
    s_mov_b64 exec, -1
    ds_read_b32 v5, v11 offset:0
    v_add_u32 v10, s23, v10
    s_ashr_i32 s25, s34, 31
    s_not_b32 s25, s25
    s_or_b32 s25, s25, 0x80000000
    s_xor_b32 s24, s34, s25
    s_and_b32 s24, s24, 0xffff0000
    v_mov_b32 v8, s24
    v_mul_f32 v8, 0xbfb8aa3b, v8
    v_exp_f32 v8, v8
    s_mov_b32 s36, 0x11111111
    s_mov_b32 s37, 0x11111111
    v_add_f32 v8, 1.0, v8
    v_rcp_f32 v8, v8
    s_lshl_b64 s[34:35], s[36:37], 2
    v_cvt_pk_bf16_f32 v8, v8, v8
    v_lshlrev_b32 v8, 16, v8
    s_waitcnt lgkmcnt(0)
    v_lshlrev_b32 v6, 16, v5
    v_and_b32 v5, 0xffff0000, v5
    v_cndmask_b32 v5, v6, v5, s[46:47]
    v_fma_f32 v5, v5, 0, v5
    v_mov_b32 v9, 0x41b80000
    v_mov_b32 v15, s30
    s_mov_b32 exec_lo, 0x77777777
    s_mov_b32 exec_hi, 0x77777777
    s_barrier
    ds_read2st64_b32 v[16:17], v12 offset0:1 offset1:2
    ds_read2st64_b32 v[18:19], v12 offset0:3 offset1:4
    ds_read2st64_b32 v[20:21], v12 offset0:5 offset1:6
    s_waitcnt lgkmcnt(1)
    v_pk_add_f32 v[16:17], v[16:17], v[18:19]
    s_waitcnt lgkmcnt(0)
    v_pk_add_f32 v[16:17], v[16:17], v[20:21]
    v_add_f32 v16, v16, v17
    v_cndmask_b32 v16, v16, 1.0, s[34:35]
    global_atomic_add_f32 v17, v13, v16, s[18:19] sc0 sc1
    s_barrier
    s_waitcnt vmcnt(0)
    v_mov_b32_dpp v18, v17 quad_perm:[2,2,2,2] row_mask:0xf bank_mask:0xf
    v_add_f32 v16, v16, v17
    v_cmp_eq_f32 vcc, v9, v18
    v_cvt_pk_bf16_f32 v16, v16, v16
    v_lshlrev_b32 v16, 16, v16
    s_and_b64 vcc, vcc, s[36:37]
    s_cbranch_scc0 L_end
    v_mul_f32 v16, v16, v8
    v_cvt_pk_bf16_f32 v16, v16, v16
    v_lshlrev_b32 v16, 16, v16
    v_add_f32 v16, v5, v16
    s_nop 1
    v_mov_b32_dpp v17, v16 quad_perm:[1,1,1,1] row_mask:0xf bank_mask:0xf
    v_cvt_pk_bf16_f32 v16, v16, v17
    s_mov_b64 exec, vcc
    global_store_dword v10, v16, s[14:15]
    s_cmp_lg_u32 s32, 0
    s_cbranch_scc1 L_end
    s_and_b64 exec, vcc, 1
    s_cbranch_scc0 L_end
    global_store_dword v7, v15, s[18:19]
L_end:
    s_endpgm
L_seg1_end:
    .p2align 12
L_warm_s:
    s_endpgm
L_spare:
    s_getreg_b32 s33, hwreg(HW_REG_XCC_ID, 0, 3)
    s_sub_u32 s31, s2, 224
    s_lshl_b32 s26, s33, 12
    s_add_u32 s26, s26, 32768
    v_lshl_add_u32 v3, v0, 6, s26
    s_cmp_lg_u32 s22, 27
    s_cbranch_scc1 L_s_noclr
    s_mul_i32 s23, s21, 1152
    s_addk_i32 s23, 16384
    v_lshl_add_u32 v1, v0, 4, s23
    v_mov_b64 v[12:13], 0
    v_mov_b64 v[14:15], 0
    global_store_dwordx4 v1, v[12:15], s[18:19] sc1
    global_store_dwordx4 v1, v[12:15], s[18:19] offset:128 sc1
    global_load_dwordx2 v[8:9], v3, s[18:19] sc1
L_s_noclr:
    s_mul_i32 s23, s21, 128
    s_mul_i32 s24, s22, 8192
    s_add_u32 s23, s23, s24
    s_add_u32 s23, s23, 32768
    v_and_b32 v41, 7, v0
    v_mul_u32_u24 v42, 128, v41
    v_lshl_add_u32 v41, v41, 3, s23
    s_lshl_b32 s23, s21, 3
    s_add_u32 s23, s23, 262144
    v_lshrrev_b32 v2, 3, v0
    v_mul_u32_u24 v2, 8192, v2
    v_add3_u32 v42, v42, v2, s23
    s_movk_i32 s24, 1152
    s_movk_i32 s25, 0x7ff
    v_mov_b32 v13, 0
    s_waitcnt lgkmcnt(0)
    s_add_u32 s30, s30, 1
    v_mov_b32 v7, s30
    s_barrier
    s_cmp_lt_u32 s31, 32
    s_cbranch_scc1 L_s_l2
    s_cmp_lg_u32 s22, 27
    s_cbranch_scc1 L_s_wait
    s_mov_b32 s29, 0
L_s_poll1:
    global_load_dwordx2 v[8:9], v40, s[18:19] sc1
    s_add_u32 s29, s29, 1
    s_cmp_lg_u32 s29, 60
    s_cbranch_scc1 L_s_same1
    v_bfe_u32 v2, v40, 7, 6
    v_cmp_ne_u32 vcc, 27, v2
    s_mov_b64 exec, vcc
    v_add_u32 v40, 65536, v40
    s_mov_b64 exec, -1
L_s_same1:
    s_cmp_gt_u32 s29, 100000
    s_cbranch_scc1 L_s_got1
    s_waitcnt vmcnt(0)
    v_cmp_ne_u32 vcc, s30, v9
    s_cbranch_vccnz L_s_poll1
L_s_got1:
    v_max_u32_dpp v8, v8, v8 row_shr:1 row_mask:0xf bank_mask:0xf
    s_nop 1
    v_max_u32_dpp v8, v8, v8 row_shr:2 row_mask:0xf bank_mask:0xf
    s_nop 1
    v_max_u32_dpp v8, v8, v8 row_shr:4 row_mask:0xf bank_mask:0xf
    s_nop 1
    v_max_u32_dpp v8, v8, v8 row_shr:8 row_mask:0xf bank_mask:0xf
    s_nop 1
    v_max_u32_dpp v8, v8, v8 row_bcast:15 row_mask:0xa bank_mask:0xf
    s_mov_b32 exec_hi, 0
    v_readlane_b32 s23, v8, 31
    s_nop 1
    v_mov_b32 v6, s23
    global_store_dwordx2 v42, v[6:7], s[18:19] sc1
L_s_wait:
    s_mov_b64 exec, 3
    s_movk_i32 s23, 12288
    v_writelane_b32 v3, s23, 1
    s_mov_b32 s29, 100000
L_s_wpoll:
    global_load_dwordx2 v[8:9], v3, s[18:19] sc1
    s_sub_u32 s29, s29, 1
    s_cbranch_scc1 L_s_nog
    s_waitcnt vmcnt(0)
    v_cmp_eq_u32 vcc, s30, v9
    v_bfi_b32 v14, v8, 0, s25
    s_cbranch_vccz L_s_wpoll
    s_mov_b64 exec, vcc
    s_branch L_s_nog
L_s_l2:
    s_mov_b32 s29, 100000
    v_min_u32 v5, 8, v0
    v_lshlrev_b32 v5, 7, v5
    v_mov_b64 v[10:11], 0
    v_not_b32 v17, v7
    s_mov_b64 exec, 0xff
L_s_poll:
    global_atomic_add_x2 v[16:17], v41, v[10:11], s[18:19] sc0 sc1
    s_waitcnt vmcnt(0)
    v_cmp_ne_u32 vcc, s30, v17
    v_max_u32_dpp v8, v16, v16 quad_perm:[1,0,3,2] row_mask:0xf bank_mask:0xf
    s_cbranch_vccz L_s_got
    s_sub_u32 s29, s29, 1
    s_cbranch_scc0 L_s_poll
L_s_got:
    s_nop 0
    v_max_u32_dpp v8, v8, v8 quad_perm:[2,3,0,1] row_mask:0xf bank_mask:0xf
    s_nop 1
    v_max_u32_dpp v8, v8, v8 row_half_mirror row_mask:0xf bank_mask:0xf
    s_mov_b64 exec, -1
    v_readfirstlane_b32 s23, v8
    s_nop 1
    v_mov_b32 v6, s23
    global_store_dwordx2 v3, v[6:7], s[18:19]
    v_bfi_b32 v14, v6, 0, s25
    v_mad_u32_u24 v5, v14, s24, v5
    global_load_dword v39, v5, s[4:5]
    s_cmp_lg_u32 s31, 7
    s_cbranch_scc1 L_s_nog
    v_mov_b32 v5, 12288
    s_mov_b64 exec, 1
    global_store_dwordx2 v5, v[6:7], s[18:19] sc1
L_s_nog:
    ds_write_b32 v13, v14 offset:128
    s_waitcnt lgkmcnt(0)
    s_barrier
    s_barrier
    s_barrier
L_s_end:
    s_endpgm
    .p2align 6
L_warm_r:
    s_endpgm
L_r2:
    v_mov_b32 v80, 0
    v_mov_b32 v81, 0
    v_mov_b32 v82, 0
    v_mov_b32 v83, 0
    v_sub_u32 v6, 0xffff, v1
    v_add_u32 v7, 65536, v3
    s_mov_b32 s25, 0xffff0000
    s_waitcnt vmcnt(10)
    ds_read_b128 v[44:47], v2 offset:2048
    ds_read_b128 v[48:51], v2 offset:2176
    ds_read_b128 v[52:55], v2 offset:2304
    ds_read_b128 v[56:59], v2 offset:2432
    ds_read_b128 v[60:63], v2 offset:2560
    ds_read_b128 v[64:67], v2 offset:2688
    ds_read_b128 v[68:71], v2 offset:2816
    ds_read_b128 v[72:75], v2 offset:2944
    ds_read_b128 v[76:79], v2 offset:3072
    s_waitcnt lgkmcnt(0)
    s_add_u32 s30, s30, 1
    v_mov_b32 v85, s30
    s_cmp_ge_u32 s22, 27
    s_waitcnt vmcnt(9)
    v_dot2c_f32_bf16 v80, v8, v44
    v_dot2c_f32_bf16 v81, v9, v45
    v_dot2c_f32_bf16 v82, v10, v46
    v_dot2c_f32_bf16 v83, v11, v47
    s_waitcnt vmcnt(8)
    v_dot2c_f32_bf16 v80, v12, v48
    v_dot2c_f32_bf16 v81, v13, v49
    v_dot2c_f32_bf16 v82, v14, v50
    v_dot2c_f32_bf16 v83, v15, v51
    s_waitcnt vmcnt(7)
    v_dot2c_f32_bf16 v80, v16, v52
    v_dot2c_f32_bf16 v81, v17, v53
    v_dot2c_f32_bf16 v82, v18, v54
    v_dot2c_f32_bf16 v83, v19, v55
    s_waitcnt vmcnt(6)
    v_dot2c_f32_bf16 v80, v20, v56
    v_dot2c_f32_bf16 v81, v21, v57
    v_dot2c_f32_bf16 v82, v22, v58
    v_dot2c_f32_bf16 v83, v23, v59
    s_waitcnt vmcnt(5)
    v_dot2c_f32_bf16 v80, v24, v60
    v_dot2c_f32_bf16 v81, v25, v61
    v_dot2c_f32_bf16 v82, v26, v62
    v_dot2c_f32_bf16 v83, v27, v63
    s_waitcnt vmcnt(4)
    v_dot2c_f32_bf16 v80, v28, v64
    v_dot2c_f32_bf16 v81, v29, v65
    v_dot2c_f32_bf16 v82, v30, v66
    v_dot2c_f32_bf16 v83, v31, v67
    s_waitcnt vmcnt(3)
    v_dot2c_f32_bf16 v80, v32, v68
    v_dot2c_f32_bf16 v81, v33, v69
    v_dot2c_f32_bf16 v82, v34, v70
    v_dot2c_f32_bf16 v83, v35, v71
    s_waitcnt vmcnt(2)
    v_dot2c_f32_bf16 v80, v36, v72
    v_dot2c_f32_bf16 v81, v37, v73
    v_dot2c_f32_bf16 v82, v38, v74
    v_dot2c_f32_bf16 v83, v39, v75
    s_waitcnt vmcnt(1)
    v_dot2c_f32_bf16 v80, v40, v76
    v_dot2c_f32_bf16 v81, v41, v77
    v_dot2c_f32_bf16 v82, v42, v78
    v_dot2c_f32_bf16 v83, v43, v79
    s_nop 2
    v_pk_add_f32 v[80:81], v[80:81], v[82:83]
    v_add_f32 v80, v80, v81
    s_nop 1
    v_add_f32_dpp v80, v80, v80 quad_perm:[1,0,3,2] row_mask:0xf bank_mask:0xf
    s_nop 1
    v_add_f32_dpp v80, v80, v80 quad_perm:[2,3,0,1] row_mask:0xf bank_mask:0xf
    s_nop 1
    v_add_f32_dpp v80, v80, v80 row_half_mirror row_mask:0xf bank_mask:0xf
    v_cmp_o_f32 vcc, v80, v80
    v_cvt_pk_bf16_f32 v86, v80, v80
    v_ashrrev_i32 v87, 31, v86
    v_or_b32 v87, 0x80000000, v87
    v_xor_b32 v86, v86, v87
    v_cndmask_b32 v86, 0, v86, vcc
    v_and_or_b32 v84, v86, s25, v6
    s_nop 1
    v_max_u32_dpp v84, v84, v84 row_shr:8 row_mask:0xf bank_mask:0xf
    s_nop 1
    v_max_u32_dpp v84, v84, v84 row_bcast:15 row_mask:0xa bank_mask:0xf
    s_nop 1
    v_max_u32_dpp v84, v84, v84 row_bcast:31 row_mask:0xc bank_mask:0xf
    s_mov_b32 exec_lo, 0
    s_brev_b32 exec_hi, 1
    s_cbranch_scc0 L_r_k1
    s_barrier
L_r_k1:
    global_store_dwordx2 v3, v[84:85], s[18:19]
    s_cbranch_scc1 L_r_k2
    s_barrier
L_r_k2:
    s_cmp_eq_u32 s22, 27
    s_cbranch_scc1 L_r_k3
    global_store_dwordx2 v7, v[84:85], s[18:19] sc1
L_r_k3:
    s_mov_b64 exec, -1
    v_mov_b32 v87, 0x207
    v_cmp_class_f32 vcc, v80, v87
    s_cbranch_vccnz L_r_fix
L_r_nofix:
    s_barrier
    v_mov_b32 v2, 0
    ds_read_b32 v2, v2 offset:128
    s_waitcnt lgkmcnt(0)
    v_cmp_ne_u32 vcc, v2, v1
    s_barrier
    s_barrier
    s_and_b64 exec, exec, vcc
    s_cmp_ge_u32 s22, 27
    s_cbranch_scc1 L_r_plain
    global_store_dwordx4 v4, v[8:11], s[14:15] offset:0 sc1
    global_store_dwordx4 v4, v[12:15], s[14:15] offset:128 sc1
    global_store_dwordx4 v4, v[16:19], s[14:15] offset:256 sc1
    global_store_dwordx4 v4, v[20:23], s[14:15] offset:384 sc1
    global_store_dwordx4 v4, v[24:27], s[14:15] offset:512 sc1
    global_store_dwordx4 v4, v[28:31], s[14:15] offset:640 sc1
    global_store_dwordx4 v4, v[32:35], s[14:15] offset:768 sc1
    global_store_dwordx4 v4, v[36:39], s[14:15] offset:896 sc1
    global_store_dwordx4 v4, v[40:43], s[14:15] offset:1024 sc1
L_r_end:
    s_endpgm
L_r_plain:
    global_store_dwordx4 v4, v[8:11], s[14:15] offset:0
    global_store_dwordx4 v4, v[12:15], s[14:15] offset:128
    global_store_dwordx4 v4, v[16:19], s[14:15] offset:256
    global_store_dwordx4 v4, v[20:23], s[14:15] offset:384
    global_store_dwordx4 v4, v[24:27], s[14:15] offset:512
    global_store_dwordx4 v4, v[28:31], s[14:15] offset:640
    global_store_dwordx4 v4, v[32:35], s[14:15] offset:768
    global_store_dwordx4 v4, v[36:39], s[14:15] offset:896
    global_store_dwordx4 v4, v[40:43], s[14:15] offset:1024
    s_branch L_r_end
L_w_far:
    s_cmp_gt_u32 s29, 100000
    s_cbranch_scc1 L_w_go
    v_xor_b32 v13, 524288, v13
    s_xor_b32 s41, s41, s33
    s_cmp_lg_u32 s29, 60
    s_cbranch_scc1 L_w_same
    v_xor_b32 v12, 524288, v12
    v_xor_b32 v179, s33, v179
    s_mov_b32 exec_hi, 0
    global_store_dwordx4 v12, v[176:179], s[18:19] sc1
    s_mov_b32 exec_hi, -1
L_w_same:
    s_waitcnt vmcnt(0)
    global_load_dwordx4 v[112:115], v13, s[18:19] offset:-2048 sc1
    global_load_dwordx4 v[116:119], v13, s[18:19] offset:-1024 sc1
    global_load_dwordx4 v[120:123], v13, s[18:19] offset:0 sc1
    global_load_dwordx4 v[124:127], v13, s[18:19] offset:1024 sc1
    s_mov_b32 exec_hi, 0
    global_load_dwordx4 v[128:131], v13, s[18:19] offset:2048 sc1
    s_mov_b32 exec_hi, -1
    s_branch L_w_chk
L_p_slow:
    v_mov_b32 v6, 12288
    s_mov_b32 s29, 100000
L_p_slowpoll:
    global_load_dwordx2 v[8:9], v6, s[18:19] sc1
    s_waitcnt vmcnt(0) lgkmcnt(0)
    v_readfirstlane_b32 s34, v8
    v_readfirstlane_b32 s35, v9
    s_sub_u32 s29, s29, 1
    s_cbranch_scc1 L_p_got
    s_cmp_lg_u32 s35, s30
    s_cbranch_scc1 L_p_slowpoll
    s_branch L_p_got
L_r_fix:
    s_mov_b32 s28, 0x07060302
    v_lshlrev_b32 v86, 16, v8
    v_and_b32 v87, s25, v8
    v_fma_f32 v86, v86, 0, v86
    v_fma_f32 v87, v87, 0, v87
    v_perm_b32 v8, v87, v86, s28
    v_lshlrev_b32 v86, 16, v9
    v_and_b32 v87, s25, v9
    v_fma_f32 v86, v86, 0, v86
    v_fma_f32 v87, v87, 0, v87
    v_perm_b32 v9, v87, v86, s28
    v_lshlrev_b32 v86, 16, v10
    v_and_b32 v87, s25, v10
    v_fma_f32 v86, v86, 0, v86
    v_fma_f32 v87, v87, 0, v87
    v_perm_b32 v10, v87, v86, s28
    v_lshlrev_b32 v86, 16, v11
    v_and_b32 v87, s25, v11
    v_fma_f32 v86, v86, 0, v86
    v_fma_f32 v87, v87, 0, v87
    v_perm_b32 v11, v87, v86, s28
    v_lshlrev_b32 v86, 16, v12
    v_and_b32 v87, s25, v12
    v_fma_f32 v86, v86, 0, v86
    v_fma_f32 v87, v87, 0, v87
    v_perm_b32 v12, v87, v86, s28
    v_lshlrev_b32 v86, 16, v13
    v_and_b32 v87, s25, v13
    v_fma_f32 v86, v86, 0, v86
    v_fma_f32 v87, v87, 0, v87
    v_perm_b32 v13, v87, v86, s28
    v_lshlrev_b32 v86, 16, v14
    v_and_b32 v87, s25, v14
    v_fma_f32 v86, v86, 0, v86
    v_fma_f32 v87, v87, 0, v87
    v_perm_b32 v14, v87, v86, s28
    v_lshlrev_b32 v86, 16, v15
    v_and_b32 v87, s25, v15
    v_fma_f32 v86, v86, 0, v86
    v_fma_f32 v87, v87, 0, v87
    v_perm_b32 v15, v87, v86, s28
    v_lshlrev_b32 v86, 16, v16
    v_and_b32 v87, s25, v16
    v_fma_f32 v86, v86, 0, v86
    v_fma_f32 v87, v87, 0, v87
    v_perm_b32 v16, v87, v86, s28
    v_lshlrev_b32 v86, 16, v17
    v_and_b32 v87, s25, v17
    v_fma_f32 v86, v86, 0, v86
    v_fma_f32 v87, v87, 0, v87
    v_perm_b32 v17, v87, v86, s28
    v_lshlrev_b32 v86, 16, v18
    v_and_b32 v87, s25, v18
    v_fma_f32 v86, v86, 0, v86
    v_fma_f32 v87, v87, 0, v87
    v_perm_b32 v18, v87, v86, s28
    v_lshlrev_b32 v86, 16, v19
    v_and_b32 v87, s25, v19
    v_fma_f32 v86, v86, 0, v86
    v_fma_f32 v87, v87, 0, v87
    v_perm_b32 v19, v87, v86, s28
    v_lshlrev_b32 v86, 16, v20
    v_and_b32 v87, s25, v20
    v_fma_f32 v86, v86, 0, v86
    v_fma_f32 v87, v87, 0, v87
    v_perm_b32 v20, v87, v86, s28
    v_lshlrev_b32 v86, 16, v21
    v_and_b32 v87, s25, v21
    v_fma_f32 v86, v86, 0, v86
    v_fma_f32 v87, v87, 0, v87
    v_perm_b32 v21, v87, v86, s28
    v_lshlrev_b32 v86, 16, v22
    v_and_b32 v87, s25, v22
    v_fma_f32 v86, v86, 0, v86
    v_fma_f32 v87, v87, 0, v87
    v_perm_b32 v22, v87, v86, s28
    v_lshlrev_b32 v86, 16, v23
    v_and_b32 v87, s25, v23
    v_fma_f32 v86, v86, 0, v86
    v_fma_f32 v87, v87, 0, v87
    v_perm_b32 v23, v87, v86, s28
    v_lshlrev_b32 v86, 16, v24
    v_and_b32 v87, s25, v24
    v_fma_f32 v86, v86, 0, v86
    v_fma_f32 v87, v87, 0, v87
    v_perm_b32 v24, v87, v86, s28
    v_lshlrev_b32 v86, 16, v25
    v_and_b32 v87, s25, v25
    v_fma_f32 v86, v86, 0, v86
    v_fma_f32 v87, v87, 0, v87
    v_perm_b32 v25, v87, v86, s28
    v_lshlrev_b32 v86, 16, v26
    v_and_b32 v87, s25, v26
    v_fma_f32 v86, v86, 0, v86
    v_fma_f32 v87, v87, 0, v87
    v_perm_b32 v26, v87, v86, s28
    v_lshlrev_b32 v86, 16, v27
    v_and_b32 v87, s25, v27
    v_fma_f32 v86, v86, 0, v86
    v_fma_f32 v87, v87, 0, v87
    v_perm_b32 v27, v87, v86, s28
    v_lshlrev_b32 v86, 16, v28
    v_and_b32 v87, s25, v28
    v_fma_f32 v86, v86, 0, v86
    v_fma_f32 v87, v87, 0, v87
    v_perm_b32 v28, v87, v86, s28
    v_lshlrev_b32 v86, 16, v29
    v_and_b32 v87, s25, v29
    v_fma_f32 v86, v86, 0, v86
    v_fma_f32 v87, v87, 0, v87
    v_perm_b32 v29, v87, v86, s28
    v_lshlrev_b32 v86, 16, v30
    v_and_b32 v87, s25, v30
    v_fma_f32 v86, v86, 0, v86
    v_fma_f32 v87, v87, 0, v87
    v_perm_b32 v30, v87, v86, s28
    v_lshlrev_b32 v86, 16, v31
    v_and_b32 v87, s25, v31
    v_fma_f32 v86, v86, 0, v86
    v_fma_f32 v87, v87, 0, v87
    v_perm_b32 v31, v87, v86, s28
    v_lshlrev_b32 v86, 16, v32
    v_and_b32 v87, s25, v32
    v_fma_f32 v86, v86, 0, v86
    v_fma_f32 v87, v87, 0, v87
    v_perm_b32 v32, v87, v86, s28
    v_lshlrev_b32 v86, 16, v33
    v_and_b32 v87, s25, v33
    v_fma_f32 v86, v86, 0, v86
    v_fma_f32 v87, v87, 0, v87
    v_perm_b32 v33, v87, v86, s28
    v_lshlrev_b32 v86, 16, v34
    v_and_b32 v87, s25, v34
    v_fma_f32 v86, v86, 0, v86
    v_fma_f32 v87, v87, 0, v87
    v_perm_b32 v34, v87, v86, s28
    v_lshlrev_b32 v86, 16, v35
    v_and_b32 v87, s25, v35
    v_fma_f32 v86, v86, 0, v86
    v_fma_f32 v87, v87, 0, v87
    v_perm_b32 v35, v87, v86, s28
    v_lshlrev_b32 v86, 16, v36
    v_and_b32 v87, s25, v36
    v_fma_f32 v86, v86, 0, v86
    v_fma_f32 v87, v87, 0, v87
    v_perm_b32 v36, v87, v86, s28
    v_lshlrev_b32 v86, 16, v37
    v_and_b32 v87, s25, v37
    v_fma_f32 v86, v86, 0, v86
    v_fma_f32 v87, v87, 0, v87
    v_perm_b32 v37, v87, v86, s28
    v_lshlrev_b32 v86, 16, v38
    v_and_b32 v87, s25, v38
    v_fma_f32 v86, v86, 0, v86
    v_fma_f32 v87, v87, 0, v87
    v_perm_b32 v38, v87, v86, s28
    v_lshlrev_b32 v86, 16, v39
    v_and_b32 v87, s25, v39
    v_fma_f32 v86, v86, 0, v86
    v_fma_f32 v87, v87, 0, v87
    v_perm_b32 v39, v87, v86, s28
    v_lshlrev_b32 v86, 16, v40
    v_and_b32 v87, s25, v40
    v_fma_f32 v86, v86, 0, v86
    v_fma_f32 v87, v87, 0, v87
    v_perm_b32 v40, v87, v86, s28
    v_lshlrev_b32 v86, 16, v41
    v_and_b32 v87, s25, v41
    v_fma_f32 v86, v86, 0, v86
    v_fma_f32 v87, v87, 0, v87
    v_perm_b32 v41, v87, v86, s28
    v_lshlrev_b32 v86, 16, v42
    v_and_b32 v87, s25, v42
    v_fma_f32 v86, v86, 0, v86
    v_fma_f32 v87, v87, 0, v87
    v_perm_b32 v42, v87, v86, s28
    v_lshlrev_b32 v86, 16, v43
    v_and_b32 v87, s25, v43
    v_fma_f32 v86, v86, 0, v86
    v_fma_f32 v87, v87, 0, v87
    v_perm_b32 v43, v87, v86, s28
    s_branch L_r_nofix
.section .rodata,"a"
.p2align 6
.amdhsa_kernel standalone__moe_arch_mod__prompt_kernel
  .amdhsa_next_free_vgpr 184
  .amdhsa_next_free_sgpr 64
  .amdhsa_accum_offset 184
  .amdhsa_group_segment_fixed_size 0
  .amdhsa_kernarg_size 64
  .amdhsa_user_sgpr_count 2
  .amdhsa_user_sgpr_kernarg_segment_ptr 1
  .amdhsa_system_sgpr_workgroup_id_x 1
  .amdhsa_float_denorm_mode_32 3
.end_amdhsa_kernel
```
